```python
import torch

def _softmax(x, axis=-1):
    return torch.softmax(x, dim=axis)
def _gelu(x):
    return torch.nn.functional.gelu(x, approximate="tanh")
def _silu(x):
    return torch.nn.functional.silu(x)
def _sigmoid(x):
    return torch.sigmoid(x)
def _layernorm(x, axis=-1, eps=1e-5):
    m = x.mean(dim=axis, keepdim=True)
    v = x.var(dim=axis, keepdim=True, unbiased=False)
    return (x - m) / torch.sqrt(v + eps)
def _scatter_add(tgt, idx, src, axis=0):
    return tgt.clone().index_add_(axis, idx, src)
def _segment_sum(src, seg, n):
    out = torch.zeros((n,) + src.shape[1:], dtype=src.dtype)
    return out.index_add_(0, seg, src)
def _pad(x, pw):
    flat = tuple(v for pair in reversed(pw) for v in pair)
    return torch.nn.functional.pad(x, flat)

kernel_name = 'standalone__rmsnorm__sampling'

def setup_inputs():

    _w = (lambda a: (lambda t: t.to(torch.bfloat16) if t.is_floating_point() else t)(torch.as_tensor(a)))
    B, S, D = 1024, 8, 1024
    return {
        "x": _w((lambda *s: torch.randn(*s, dtype=torch.bfloat16) * 0.05)(B, S, D)),
        "g": _w((lambda *s: torch.randn(*s, dtype=torch.bfloat16) * 0.05)(D) + 1.0),
    }

def reference(x, g):
    rms = torch.sqrt((x * x).mean(axis=-1, keepdims=True) + 1e-6)
    return x / rms * g
```

```asm
; @launch grid=(512,1,1) block=(256,1,1) lds=0
.amdgcn_target "amdgcn-amd-amdhsa--gfx950"
.text
.p2align 12
.globl standalone__rmsnorm__sampling_kernel
.p2align 8
.type standalone__rmsnorm__sampling_kernel,@function
standalone__rmsnorm__sampling_kernel:
    s_load_dwordx8 s[4:11], s[0:1], 0
    s_setprio 3
    s_lshl_b32 s3, s2, 15
    v_and_b32 v1, 63, v0
    v_lshlrev_b32 v1, 4, v1
    v_or_b32 v2, s3, v1
    v_lshrrev_b32 v3, 6, v0
    v_lshl_or_b32 v2, v3, 13, v2
    v_or_b32 v3, 0x1000, v2
    s_mov_b32 s12, 0xffff0000
    s_mov_b32 s13, 0x3a800000
    v_mov_b32 v5, 0x358637bd
    s_cmpk_lt_u32 s2, 512
    s_cbranch_scc1 L_touch
    s_endpgm
L_main:
    s_cmp_lg_u32 0, 0
    s_waitcnt lgkmcnt(0)
    global_load_dwordx4 v[24:27], v2, s[4:5] offset:0 nt
    global_load_dwordx4 v[28:31], v2, s[4:5] offset:1024 nt
    global_load_dwordx4 v[8:11], v1, s[6:7] offset:0
    global_load_dwordx4 v[12:15], v1, s[6:7] offset:1024
    global_load_dwordx4 v[32:35], v2, s[4:5] offset:2048 nt
    global_load_dwordx4 v[36:39], v2, s[4:5] offset:3072 nt
    global_load_dwordx4 v[40:43], v3, s[4:5] offset:0 nt
    global_load_dwordx4 v[44:47], v3, s[4:5] offset:1024 nt
    global_load_dwordx4 v[48:51], v3, s[4:5] offset:2048 nt
    global_load_dwordx4 v[52:55], v3, s[4:5] offset:3072 nt
    s_setprio 0
    v_mov_b32 v4, 0
    s_waitcnt vmcnt(8)
    v_dot2c_f32_bf16 v4, v24, v24
    v_dot2c_f32_bf16 v4, v25, v25
    v_dot2c_f32_bf16 v4, v26, v26
    v_dot2c_f32_bf16 v4, v27, v27
    v_dot2c_f32_bf16 v4, v28, v28
    v_dot2c_f32_bf16 v4, v29, v29
    v_dot2c_f32_bf16 v4, v30, v30
    v_dot2c_f32_bf16 v4, v31, v31
    s_waitcnt vmcnt(6)
    v_and_b32 v16, 0xffff, v8
    v_and_b32 v8, s12, v8
    v_and_b32 v17, 0xffff, v9
    v_and_b32 v9, s12, v9
    v_and_b32 v18, 0xffff, v10
    v_and_b32 v10, s12, v10
    v_and_b32 v19, 0xffff, v11
    v_and_b32 v11, s12, v11
    v_and_b32 v20, 0xffff, v12
    v_and_b32 v12, s12, v12
    v_and_b32 v21, 0xffff, v13
    v_and_b32 v13, s12, v13
    v_and_b32 v22, 0xffff, v14
    v_and_b32 v14, s12, v14
    v_and_b32 v23, 0xffff, v15
    v_and_b32 v15, s12, v15
    v_dot2_f32_bf16 v56, v24, v16, 0
    v_dot2_f32_bf16 v57, v24, v8, 0
    v_dot2_f32_bf16 v58, v25, v17, 0
    v_add_f32_dpp v4, v4, v4 quad_perm:[1,0,3,2] row_mask:0xf bank_mask:0xf
    v_dot2_f32_bf16 v59, v25, v9, 0
    v_dot2_f32_bf16 v60, v26, v18, 0
    v_add_f32_dpp v4, v4, v4 quad_perm:[2,3,0,1] row_mask:0xf bank_mask:0xf
    v_dot2_f32_bf16 v61, v26, v10, 0
    v_dot2_f32_bf16 v62, v27, v19, 0
    v_add_f32_dpp v4, v4, v4 row_half_mirror row_mask:0xf bank_mask:0xf
    v_dot2_f32_bf16 v63, v27, v11, 0
    v_dot2_f32_bf16 v64, v28, v20, 0
    v_add_f32_dpp v4, v4, v4 row_mirror row_mask:0xf bank_mask:0xf
    v_dot2_f32_bf16 v65, v28, v12, 0
    v_dot2_f32_bf16 v66, v29, v21, 0
    v_add_f32_dpp v4, v4, v4 row_bcast:15 row_mask:0xa bank_mask:0xf
    v_dot2_f32_bf16 v67, v29, v13, 0
    v_dot2_f32_bf16 v68, v30, v22, 0
    v_add_f32_dpp v4, v4, v4 row_bcast:31 row_mask:0xc bank_mask:0xf
    v_fma_f32 v4, v4, s13, v5
    v_rsq_f32 v4, v4
    v_dot2_f32_bf16 v69, v30, v14, 0
    v_readlane_b32 s14, v4, 63
    v_dot2_f32_bf16 v70, v31, v23, 0
    v_dot2_f32_bf16 v71, v31, v15, 0
    v_pk_mul_f32 v[56:57], v[56:57], s[14:15] op_sel_hi:[1,0]
    v_pk_mul_f32 v[58:59], v[58:59], s[14:15] op_sel_hi:[1,0]
    v_pk_mul_f32 v[60:61], v[60:61], s[14:15] op_sel_hi:[1,0]
    v_pk_mul_f32 v[62:63], v[62:63], s[14:15] op_sel_hi:[1,0]
    v_pk_mul_f32 v[64:65], v[64:65], s[14:15] op_sel_hi:[1,0]
    v_pk_mul_f32 v[66:67], v[66:67], s[14:15] op_sel_hi:[1,0]
    v_pk_mul_f32 v[68:69], v[68:69], s[14:15] op_sel_hi:[1,0]
    v_pk_mul_f32 v[70:71], v[70:71], s[14:15] op_sel_hi:[1,0]
    v_cvt_pk_bf16_f32 v24, v56, v57
    v_cvt_pk_bf16_f32 v25, v58, v59
    v_cvt_pk_bf16_f32 v26, v60, v61
    v_cvt_pk_bf16_f32 v27, v62, v63
    v_cvt_pk_bf16_f32 v28, v64, v65
    v_cvt_pk_bf16_f32 v29, v66, v67
    v_cvt_pk_bf16_f32 v30, v68, v69
    v_cvt_pk_bf16_f32 v31, v70, v71
    v_mov_b32 v4, 0
    s_waitcnt vmcnt(4)
    v_dot2c_f32_bf16 v4, v32, v32
    v_dot2c_f32_bf16 v4, v33, v33
    v_dot2c_f32_bf16 v4, v34, v34
    v_dot2c_f32_bf16 v4, v35, v35
    v_dot2c_f32_bf16 v4, v36, v36
    v_dot2c_f32_bf16 v4, v37, v37
    v_dot2c_f32_bf16 v4, v38, v38
    v_dot2c_f32_bf16 v4, v39, v39
    v_dot2_f32_bf16 v56, v32, v16, 0
    v_dot2_f32_bf16 v57, v32, v8, 0
    v_dot2_f32_bf16 v58, v33, v17, 0
    v_add_f32_dpp v4, v4, v4 quad_perm:[1,0,3,2] row_mask:0xf bank_mask:0xf
    v_dot2_f32_bf16 v59, v33, v9, 0
    v_dot2_f32_bf16 v60, v34, v18, 0
    v_add_f32_dpp v4, v4, v4 quad_perm:[2,3,0,1] row_mask:0xf bank_mask:0xf
    v_dot2_f32_bf16 v61, v34, v10, 0
    v_dot2_f32_bf16 v62, v35, v19, 0
    v_add_f32_dpp v4, v4, v4 row_half_mirror row_mask:0xf bank_mask:0xf
    v_dot2_f32_bf16 v63, v35, v11, 0
    v_dot2_f32_bf16 v64, v36, v20, 0
    v_add_f32_dpp v4, v4, v4 row_mirror row_mask:0xf bank_mask:0xf
    v_dot2_f32_bf16 v65, v36, v12, 0
    v_dot2_f32_bf16 v66, v37, v21, 0
    v_add_f32_dpp v4, v4, v4 row_bcast:15 row_mask:0xa bank_mask:0xf
    v_dot2_f32_bf16 v67, v37, v13, 0
    v_dot2_f32_bf16 v68, v38, v22, 0
    v_add_f32_dpp v4, v4, v4 row_bcast:31 row_mask:0xc bank_mask:0xf
    v_fma_f32 v4, v4, s13, v5
    v_rsq_f32 v4, v4
    v_dot2_f32_bf16 v69, v38, v14, 0
    v_readlane_b32 s14, v4, 63
    v_dot2_f32_bf16 v70, v39, v23, 0
    v_dot2_f32_bf16 v71, v39, v15, 0
    v_pk_mul_f32 v[56:57], v[56:57], s[14:15] op_sel_hi:[1,0]
    v_pk_mul_f32 v[58:59], v[58:59], s[14:15] op_sel_hi:[1,0]
    v_pk_mul_f32 v[60:61], v[60:61], s[14:15] op_sel_hi:[1,0]
    v_pk_mul_f32 v[62:63], v[62:63], s[14:15] op_sel_hi:[1,0]
    v_pk_mul_f32 v[64:65], v[64:65], s[14:15] op_sel_hi:[1,0]
    v_pk_mul_f32 v[66:67], v[66:67], s[14:15] op_sel_hi:[1,0]
    v_pk_mul_f32 v[68:69], v[68:69], s[14:15] op_sel_hi:[1,0]
    v_pk_mul_f32 v[70:71], v[70:71], s[14:15] op_sel_hi:[1,0]
    v_cvt_pk_bf16_f32 v32, v56, v57
    v_cvt_pk_bf16_f32 v33, v58, v59
    v_cvt_pk_bf16_f32 v34, v60, v61
    v_cvt_pk_bf16_f32 v35, v62, v63
    v_cvt_pk_bf16_f32 v36, v64, v65
    v_cvt_pk_bf16_f32 v37, v66, v67
    v_cvt_pk_bf16_f32 v38, v68, v69
    v_cvt_pk_bf16_f32 v39, v70, v71
    v_mov_b32 v4, 0
    s_waitcnt vmcnt(2)
    v_dot2c_f32_bf16 v4, v40, v40
    v_dot2c_f32_bf16 v4, v41, v41
    v_dot2c_f32_bf16 v4, v42, v42
    v_dot2c_f32_bf16 v4, v43, v43
    v_dot2c_f32_bf16 v4, v44, v44
L_touch:
    s_cbranch_scc1 L_main
    v_dot2c_f32_bf16 v4, v45, v45
    v_dot2c_f32_bf16 v4, v46, v46
    v_dot2c_f32_bf16 v4, v47, v47
    v_dot2_f32_bf16 v56, v40, v16, 0
    v_dot2_f32_bf16 v57, v40, v8, 0
    v_dot2_f32_bf16 v58, v41, v17, 0
    v_add_f32_dpp v4, v4, v4 quad_perm:[1,0,3,2] row_mask:0xf bank_mask:0xf
    v_dot2_f32_bf16 v59, v41, v9, 0
    v_dot2_f32_bf16 v60, v42, v18, 0
    v_add_f32_dpp v4, v4, v4 quad_perm:[2,3,0,1] row_mask:0xf bank_mask:0xf
    v_dot2_f32_bf16 v61, v42, v10, 0
    v_dot2_f32_bf16 v62, v43, v19, 0
    v_add_f32_dpp v4, v4, v4 row_half_mirror row_mask:0xf bank_mask:0xf
    v_dot2_f32_bf16 v63, v43, v11, 0
    v_dot2_f32_bf16 v64, v44, v20, 0
    v_add_f32_dpp v4, v4, v4 row_mirror row_mask:0xf bank_mask:0xf
    v_dot2_f32_bf16 v65, v44, v12, 0
    v_dot2_f32_bf16 v66, v45, v21, 0
    v_add_f32_dpp v4, v4, v4 row_bcast:15 row_mask:0xa bank_mask:0xf
    v_dot2_f32_bf16 v67, v45, v13, 0
    v_dot2_f32_bf16 v68, v46, v22, 0
    v_add_f32_dpp v4, v4, v4 row_bcast:31 row_mask:0xc bank_mask:0xf
    v_fma_f32 v4, v4, s13, v5
    v_rsq_f32 v4, v4
    v_dot2_f32_bf16 v69, v46, v14, 0
    v_readlane_b32 s14, v4, 63
    v_dot2_f32_bf16 v70, v47, v23, 0
    v_dot2_f32_bf16 v71, v47, v15, 0
    v_pk_mul_f32 v[56:57], v[56:57], s[14:15] op_sel_hi:[1,0]
    v_pk_mul_f32 v[58:59], v[58:59], s[14:15] op_sel_hi:[1,0]
    v_pk_mul_f32 v[60:61], v[60:61], s[14:15] op_sel_hi:[1,0]
    v_pk_mul_f32 v[62:63], v[62:63], s[14:15] op_sel_hi:[1,0]
    v_pk_mul_f32 v[64:65], v[64:65], s[14:15] op_sel_hi:[1,0]
    v_pk_mul_f32 v[66:67], v[66:67], s[14:15] op_sel_hi:[1,0]
    v_pk_mul_f32 v[68:69], v[68:69], s[14:15] op_sel_hi:[1,0]
    v_pk_mul_f32 v[70:71], v[70:71], s[14:15] op_sel_hi:[1,0]
    v_cvt_pk_bf16_f32 v40, v56, v57
    v_cvt_pk_bf16_f32 v41, v58, v59
    v_cvt_pk_bf16_f32 v42, v60, v61
    v_cvt_pk_bf16_f32 v43, v62, v63
    v_cvt_pk_bf16_f32 v44, v64, v65
    v_cvt_pk_bf16_f32 v45, v66, v67
    v_cvt_pk_bf16_f32 v46, v68, v69
    v_cvt_pk_bf16_f32 v47, v70, v71
    v_mov_b32 v4, 0
    s_waitcnt vmcnt(0)
    v_dot2c_f32_bf16 v4, v48, v48
    v_dot2c_f32_bf16 v4, v49, v49
    v_dot2c_f32_bf16 v4, v50, v50
    v_dot2c_f32_bf16 v4, v51, v51
    v_dot2c_f32_bf16 v4, v52, v52
    v_dot2c_f32_bf16 v4, v53, v53
    v_dot2c_f32_bf16 v4, v54, v54
    v_dot2c_f32_bf16 v4, v55, v55
    v_dot2_f32_bf16 v56, v48, v16, 0
    v_dot2_f32_bf16 v57, v48, v8, 0
    v_dot2_f32_bf16 v58, v49, v17, 0
    v_add_f32_dpp v4, v4, v4 quad_perm:[1,0,3,2] row_mask:0xf bank_mask:0xf
    v_dot2_f32_bf16 v59, v49, v9, 0
    v_dot2_f32_bf16 v60, v50, v18, 0
    v_add_f32_dpp v4, v4, v4 quad_perm:[2,3,0,1] row_mask:0xf bank_mask:0xf
    v_dot2_f32_bf16 v61, v50, v10, 0
    v_dot2_f32_bf16 v62, v51, v19, 0
    v_add_f32_dpp v4, v4, v4 row_half_mirror row_mask:0xf bank_mask:0xf
    v_dot2_f32_bf16 v63, v51, v11, 0
    v_dot2_f32_bf16 v64, v52, v20, 0
    v_add_f32_dpp v4, v4, v4 row_mirror row_mask:0xf bank_mask:0xf
    v_dot2_f32_bf16 v65, v52, v12, 0
    v_dot2_f32_bf16 v66, v53, v21, 0
    v_add_f32_dpp v4, v4, v4 row_bcast:15 row_mask:0xa bank_mask:0xf
    v_dot2_f32_bf16 v67, v53, v13, 0
    v_dot2_f32_bf16 v68, v54, v22, 0
    v_add_f32_dpp v4, v4, v4 row_bcast:31 row_mask:0xc bank_mask:0xf
    v_fma_f32 v4, v4, s13, v5
    v_rsq_f32 v4, v4
    v_dot2_f32_bf16 v69, v54, v14, 0
    v_readlane_b32 s14, v4, 63
    v_dot2_f32_bf16 v70, v55, v23, 0
    v_dot2_f32_bf16 v71, v55, v15, 0
    v_pk_mul_f32 v[56:57], v[56:57], s[14:15] op_sel_hi:[1,0]
    v_pk_mul_f32 v[58:59], v[58:59], s[14:15] op_sel_hi:[1,0]
    v_pk_mul_f32 v[60:61], v[60:61], s[14:15] op_sel_hi:[1,0]
    v_pk_mul_f32 v[62:63], v[62:63], s[14:15] op_sel_hi:[1,0]
    v_pk_mul_f32 v[64:65], v[64:65], s[14:15] op_sel_hi:[1,0]
    v_pk_mul_f32 v[66:67], v[66:67], s[14:15] op_sel_hi:[1,0]
    v_pk_mul_f32 v[68:69], v[68:69], s[14:15] op_sel_hi:[1,0]
    v_pk_mul_f32 v[70:71], v[70:71], s[14:15] op_sel_hi:[1,0]
    v_cvt_pk_bf16_f32 v48, v56, v57
    v_cvt_pk_bf16_f32 v49, v58, v59
    v_cvt_pk_bf16_f32 v50, v60, v61
    v_cvt_pk_bf16_f32 v51, v62, v63
    v_cvt_pk_bf16_f32 v52, v64, v65
    v_cvt_pk_bf16_f32 v53, v66, v67
    v_cvt_pk_bf16_f32 v54, v68, v69
    v_cvt_pk_bf16_f32 v55, v70, v71
    global_store_dwordx4 v2, v[24:27], s[8:9] offset:0 nt
    global_store_dwordx4 v2, v[28:31], s[8:9] offset:1024 nt
    global_store_dwordx4 v2, v[32:35], s[8:9] offset:2048 nt
    global_store_dwordx4 v2, v[36:39], s[8:9] offset:3072 nt
    global_store_dwordx4 v3, v[40:43], s[8:9] offset:0 nt
    global_store_dwordx4 v3, v[44:47], s[8:9] offset:1024 nt
    global_store_dwordx4 v3, v[48:51], s[8:9] offset:2048 nt
    global_store_dwordx4 v3, v[52:55], s[8:9] offset:3072 nt
    s_endpgm
.section .rodata,"a"
.p2align 6
.amdhsa_kernel standalone__rmsnorm__sampling_kernel
  .amdhsa_next_free_vgpr 72
  .amdhsa_next_free_sgpr 16
  .amdhsa_accum_offset 72
  .amdhsa_group_segment_fixed_size 0
  .amdhsa_kernarg_size 40
  .amdhsa_user_sgpr_count 2
  .amdhsa_user_sgpr_kernarg_segment_ptr 1
  .amdhsa_system_sgpr_workgroup_id_x 1
  .amdhsa_float_denorm_mode_32 3
.end_amdhsa_kernel
```
